```python
import torch

def _softmax(x, axis=-1):
    return torch.softmax(x, dim=axis)
def _gelu(x):
    return torch.nn.functional.gelu(x, approximate="tanh")
def _silu(x):
    return torch.nn.functional.silu(x)
def _sigmoid(x):
    return torch.sigmoid(x)
def _layernorm(x, axis=-1, eps=1e-5):
    m = x.mean(dim=axis, keepdim=True)
    v = x.var(dim=axis, keepdim=True, unbiased=False)
    return (x - m) / torch.sqrt(v + eps)
def _scatter_add(tgt, idx, src, axis=0):
    return tgt.clone().index_add_(axis, idx, src)
def _segment_sum(src, seg, n):
    out = torch.zeros((n,) + src.shape[1:], dtype=src.dtype)
    return out.index_add_(0, seg, src)
def _pad(x, pw):
    flat = tuple(v for pair in reversed(pw) for v in pair)
    return torch.nn.functional.pad(x, flat)

kernel_name = 'standalone__sparse_matmul_formats_ell__sparse_mat'

def setup_inputs():

    _w = (lambda a: (lambda t: t.to(torch.bfloat16) if t.is_floating_point() else t)(torch.as_tensor(a)))
    M = N = 65536
    D = 64
    K = max(1, int(0.001 * N))
    col_idx = (lambda lo, hi, *s: torch.randint(lo, hi, s))(0, N, M, K)
    vals = (lambda *s: torch.randn(*s, dtype=torch.bfloat16) * 0.05)(M, K)
    lengths = (lambda lo, hi, *s: torch.randint(lo, hi, s))(1, K + 1, M)
    mask = (torch.arange(K)[None, :] < lengths[:, None]).to(vals.dtype)
    vals = vals * mask
    b = (lambda *s: torch.randn(*s, dtype=torch.bfloat16) * 0.05)(N, D)
    return {
        "vals": _w(vals),
        "col_idx": _w(col_idx),
        "b": _w(b),
    }

def reference(vals, col_idx, b):
    gathered = b[col_idx]
    return torch.einsum("mk,mkd->md", vals, gathered)
```

```asm
; @launch grid=(256,1,1) block=(1024,1,1) lds=151616
.amdgcn_target "amdgcn-amd-amdhsa--gfx950"
.text
.globl standalone__sparse_matmul_formats_ell__sparse_mat_kernel
.p2align 12
.type standalone__sparse_matmul_formats_ell__sparse_mat_kernel,@function
standalone__sparse_matmul_formats_ell__sparse_mat_kernel:
    s_cmpk_ge_u32 s2, 256
    s_cbranch_scc1 L_end
    s_load_dwordx8 s[12:19], s[0:1], 0
    v_lshl_or_b32 v7, s2, 10, v0
    v_lshrrev_b32 v7, 2, v7
    v_and_b32 v8, 3, v0
    v_lshl_add_u32 v24, v7, 6, v7
    v_and_b32 v9, 1, v7
    v_lshlrev_b32 v8, 3, v8
    v_add3_u32 v23, v24, v9, v8
    v_lshlrev_b32 v8, 1, v23
    v_lshlrev_b32 v23, 2, v23
    v_lshlrev_b32 v9, 6, v9
    v_sub_u32 v24, v24, v9
    v_lshlrev_b32 v9, 1, v24
    v_lshlrev_b32 v24, 2, v24
    s_setprio 3
    s_waitcnt lgkmcnt(0)
    global_load_dwordx4 v[50:53], v8, s[12:13]
    global_load_dwordx4 v[54:57], v8, s[12:13] offset:64
    global_load_dwordx4 v[32:35], v23, s[14:15]
    global_load_dwordx4 v[36:39], v23, s[14:15] offset:16
    global_load_dwordx4 v[40:43], v23, s[14:15] offset:128
    global_load_dwordx4 v[44:47], v23, s[14:15] offset:144
    global_load_ushort v58, v9, s[12:13] offset:128
    global_load_dword v48, v24, s[14:15] offset:256
    v_lshrrev_b32 v9, 6, v0
    v_and_b32 v1, 63, v0
    v_readfirstlane_b32 s28, v9
    s_mul_i32 s29, s2, 16
    s_mov_b32 s22, 8388608
    s_mov_b32 s23, 0x20000
    s_mov_b32 s26, 8388608
    s_mov_b32 s27, 0x20000
    s_and_b32 s30, s2, 7
    s_mov_b64 s[20:21], s[16:17]
    s_mov_b64 s[24:25], s[18:19]
    s_add_u32 s29, s29, s28
    s_mul_i32 s39, s28, 9472
    v_mov_b32 v16, 0x10000
    v_mov_b32 v17, 0
    s_mov_b32 s31, 151552
    v_and_b32 v0, 15, v1
    s_lshl_b32 s32, s28, 2
    v_lshl_add_u32 v0, v0, 2, s31
    s_add_u32 s3, s31, s32
    v_mov_b32 v8, s3
    v_mov_b32 v9, -1
    s_mov_b64 exec, 1
    ds_write_b32 v8, v9
    s_mov_b64 exec, -1
    v_lshrrev_b32 v8, 5, v1
    s_add_u32 s31, s39, 9216
    v_lshl_add_u32 v5, v8, 7, s31
    v_mul_u32_u24 v8, 2272, v8
    v_add_u32 v25, s39, v8
    v_and_b32 v8, 31, v1
    v_lshl_add_u32 v26, v8, 2, v25
    v_mov_b32 v21, s31
    v_add_u32 v22, 128, v21
    s_lshl_b32 s32, s30, 3
    s_and_b32 s33, s30, 4
    s_add_u32 s32, s32, s33
    v_add_u32 v9, s32, v1
    v_lshlrev_b32 v10, 2, v9
    v_and_b32 v10, 16, v10
    v_xor_b32 v9, v10, v9
    v_and_b32 v9, 31, v9
    v_lshl_add_u32 v10, v9, 2, v5
    ds_write_b32 v10, v17
    v_and_b32 v7, 7, v7
    v_lshlrev_b32 v6, 17, v7
    v_and_b32 v7, 7, v1
    v_lshlrev_b32 v2, 4, v7
    v_mul_u32_u24 v20, 0x49, v7
    v_and_b32 v20, 0x111, v20
    v_lshrrev_b32 v8, 3, v1
    v_mul_u32_u24 v8, 0x49, v8
    v_and_b32 v8, 0x111, v8
    v_lshl_or_b32 v20, v8, 12, v20
    v_mul_u32_u24 v20, 0xf0, v20
    v_not_b32 v20, v20
    v_lshlrev_b32 v7, 17, v7
    v_xor_b32 v3, 0xffff8000, v7
    v_bfe_u32 v7, v1, 3, 1
    v_mul_u32_u24 v7, 2272, v7
    v_and_b32 v8, 48, v1
    v_lshrrev_b32 v8, 1, v8
    v_add3_u32 v4, v7, v8, s39
    v_mov_b32 v11, 4
    s_mov_b32 s34, 0x05040100
    s_mov_b32 s35, 0x07060302
    s_mov_b32 s36, 0x8000
    s_mov_b32 s37, 124
    s_mov_b32 s74, 0
    s_waitcnt vmcnt(6)
    v_or_b32_sdwa v65, v6, v50 dst_sel:DWORD dst_unused:UNUSED_PAD src0_sel:DWORD src1_sel:WORD_1
    v_or_b32_sdwa v69, v6, v52 dst_sel:DWORD dst_unused:UNUSED_PAD src0_sel:DWORD src1_sel:WORD_1
    v_or_b32_sdwa v73, v6, v54 dst_sel:DWORD dst_unused:UNUSED_PAD src0_sel:DWORD src1_sel:WORD_1
    v_or_b32_sdwa v77, v6, v56 dst_sel:DWORD dst_unused:UNUSED_PAD src0_sel:DWORD src1_sel:WORD_1
    v_cmp_neq_f16_e64 s[42:43], 0, v65
    v_cmp_neq_f16_e64 s[50:51], 0, v69
    v_cmp_neq_f16_e64 s[58:59], 0, v73
    v_cmp_neq_f16_e64 s[66:67], 0, v77
    v_or_b32_sdwa v64, v6, v50 dst_sel:DWORD dst_unused:UNUSED_PAD src0_sel:DWORD src1_sel:WORD_0
    v_or_b32_sdwa v66, v6, v51 dst_sel:DWORD dst_unused:UNUSED_PAD src0_sel:DWORD src1_sel:WORD_0
    v_or_b32_sdwa v67, v6, v51 dst_sel:DWORD dst_unused:UNUSED_PAD src0_sel:DWORD src1_sel:WORD_1
    v_or_b32_sdwa v68, v6, v52 dst_sel:DWORD dst_unused:UNUSED_PAD src0_sel:DWORD src1_sel:WORD_0
    v_cmp_neq_f16_e64 s[40:41], 0, v64
    v_cmp_neq_f16_e64 s[44:45], 0, v66
    v_cmp_neq_f16_e64 s[46:47], 0, v67
    v_cmp_neq_f16_e64 s[48:49], 0, v68
    v_or_b32_sdwa v70, v6, v53 dst_sel:DWORD dst_unused:UNUSED_PAD src0_sel:DWORD src1_sel:WORD_0
    v_or_b32_sdwa v71, v6, v53 dst_sel:DWORD dst_unused:UNUSED_PAD src0_sel:DWORD src1_sel:WORD_1
    v_or_b32_sdwa v72, v6, v54 dst_sel:DWORD dst_unused:UNUSED_PAD src0_sel:DWORD src1_sel:WORD_0
    v_or_b32_sdwa v74, v6, v55 dst_sel:DWORD dst_unused:UNUSED_PAD src0_sel:DWORD src1_sel:WORD_0
    v_cmp_neq_f16_e64 s[52:53], 0, v70
    v_cmp_neq_f16_e64 s[54:55], 0, v71
    v_cmp_neq_f16_e64 s[56:57], 0, v72
    v_cmp_neq_f16_e64 s[60:61], 0, v74
    v_or_b32_sdwa v75, v6, v55 dst_sel:DWORD dst_unused:UNUSED_PAD src0_sel:DWORD src1_sel:WORD_1
    v_or_b32_sdwa v76, v6, v56 dst_sel:DWORD dst_unused:UNUSED_PAD src0_sel:DWORD src1_sel:WORD_0
    v_or_b32_sdwa v78, v6, v57 dst_sel:DWORD dst_unused:UNUSED_PAD src0_sel:DWORD src1_sel:WORD_0
    v_or_b32_sdwa v79, v6, v57 dst_sel:DWORD dst_unused:UNUSED_PAD src0_sel:DWORD src1_sel:WORD_1
    v_cmp_neq_f16_e64 s[62:63], 0, v75
    v_cmp_neq_f16_e64 s[64:65], 0, v76
    v_cmp_neq_f16_e64 s[68:69], 0, v78
    v_cmp_neq_f16_e64 s[70:71], 0, v79
    s_xor_b32 s4, s42, s43
    s_bcnt1_i32_b64 s8, s[42:43]
    s_xor_b32 s5, s50, s51
    s_bcnt1_i32_b64 s9, s[50:51]
    s_xor_b32 s6, s58, s59
    s_bcnt1_i32_b64 s10, s[58:59]
    s_xor_b32 s7, s66, s67
    s_bcnt1_i32_b64 s11, s[66:67]
    v_and_b32 v7, s4, v20
    v_xor_b32 v7, s43, v7
    v_bcnt_u32_b32 v8, v7, 0
    v_and_b32 v7, s5, v20
    v_xor_b32 v7, s51, v7
    v_bcnt_u32_b32 v8, v7, v8
    v_and_b32 v7, s6, v20
    v_xor_b32 v7, s59, v7
    v_bcnt_u32_b32 v8, v7, v8
    v_and_b32 v7, s7, v20
    v_xor_b32 v7, s67, v7
    v_bcnt_u32_b32 v8, v7, v8
    s_add_u32 s8, s8, s9
    s_add_u32 s10, s10, s11
    s_add_u32 s8, s8, s10
    s_lshl_b32 s8, s8, 6
    v_lshlrev_b32 v8, 7, v8
    v_sad_u32 v8, v8, s8, v1
    s_nop 1
    v_min_u32_dpp v8, v8, v8 row_shr:1
    s_nop 1
    v_min_u32_dpp v8, v8, v8 row_shr:2
    s_nop 1
    v_min_u32_dpp v8, v8, v8 row_shr:4
    s_nop 1
    v_min_u32_dpp v8, v8, v8 row_shr:8
    s_nop 1
    v_min_u32_dpp v8, v8, v8 row_bcast:15 row_mask:0xa
    s_nop 1
    v_min_u32_dpp v8, v8, v8 row_bcast:31 row_mask:0xc
    s_nop 0
    v_readlane_b32 s74, v8, 63
    s_and_b32 s74, s74, 63
    v_readlane_b32 s5, v20, s74
    s_not_b32 s4, s5
    s_lshl_b32 s74, s74, 1
    s_nop 0
    v_cndmask_b32_e64 v5, v21, v22, s[4:5]
    s_waitcnt vmcnt(4)
    v_lshrrev_b32 v81, 10, v32
    v_and_or_b32 v81, v32, 64, v81
    v_and_or_b32 v81, v81, s37, v5
    v_lshrrev_b32 v82, 10, v33
    v_and_or_b32 v82, v33, 64, v82
    v_and_or_b32 v82, v82, s37, v5
    v_lshrrev_b32 v83, 10, v34
    v_and_or_b32 v83, v34, 64, v83
    v_and_or_b32 v83, v83, s37, v5
    v_lshrrev_b32 v84, 10, v35
    v_and_or_b32 v84, v35, 64, v84
    v_and_or_b32 v84, v84, s37, v5
    v_lshrrev_b32 v85, 10, v36
    v_and_or_b32 v85, v36, 64, v85
    v_and_or_b32 v85, v85, s37, v5
    v_lshrrev_b32 v86, 10, v37
    v_and_or_b32 v86, v37, 64, v86
    v_and_or_b32 v86, v86, s37, v5
    v_lshrrev_b32 v87, 10, v38
    v_and_or_b32 v87, v38, 64, v87
    v_and_or_b32 v87, v87, s37, v5
    v_lshrrev_b32 v88, 10, v39
    v_and_or_b32 v88, v39, 64, v88
    v_and_or_b32 v88, v88, s37, v5
    s_mov_b64 exec, s[40:41]
    ds_add_rtn_u32 v98, v81, v11
    s_mov_b64 exec, s[42:43]
    ds_add_rtn_u32 v99, v82, v11
    s_mov_b64 exec, s[44:45]
    ds_add_rtn_u32 v100, v83, v11
    s_mov_b64 exec, s[46:47]
    ds_add_rtn_u32 v101, v84, v11
    s_mov_b64 exec, s[48:49]
    ds_add_rtn_u32 v102, v85, v11
    s_mov_b64 exec, s[50:51]
    ds_add_rtn_u32 v103, v86, v11
    s_mov_b64 exec, s[52:53]
    ds_add_rtn_u32 v104, v87, v11
    s_mov_b64 exec, s[54:55]
    ds_add_rtn_u32 v105, v88, v11
    s_mov_b64 exec, -1
    s_waitcnt vmcnt(0)
    v_or_b32_sdwa v80, v6, v58 dst_sel:DWORD dst_unused:UNUSED_PAD src0_sel:DWORD src1_sel:WORD_0
    v_cmp_neq_f16_e64 s[72:73], 0, v80
    s_mov_b32 s31, 0x11111111
    s_and_b32 s72, s72, s31
    s_and_b32 s73, s73, s31
    v_lshrrev_b32 v89, 10, v40
    v_and_or_b32 v89, v40, 64, v89
    v_and_or_b32 v89, v89, s37, v5
    v_lshrrev_b32 v90, 10, v41
    v_and_or_b32 v90, v41, 64, v90
    v_and_or_b32 v90, v90, s37, v5
    v_lshrrev_b32 v91, 10, v42
    v_and_or_b32 v91, v42, 64, v91
    v_and_or_b32 v91, v91, s37, v5
    v_lshrrev_b32 v92, 10, v43
    v_and_or_b32 v92, v43, 64, v92
    v_and_or_b32 v92, v92, s37, v5
    v_lshrrev_b32 v93, 10, v44
    v_and_or_b32 v93, v44, 64, v93
    v_and_or_b32 v93, v93, s37, v5
    v_lshrrev_b32 v94, 10, v45
    v_and_or_b32 v94, v45, 64, v94
    v_and_or_b32 v94, v94, s37, v5
    v_lshrrev_b32 v95, 10, v46
    v_and_or_b32 v95, v46, 64, v95
    v_and_or_b32 v95, v95, s37, v5
    v_lshrrev_b32 v96, 10, v47
    v_and_or_b32 v96, v47, 64, v96
    v_and_or_b32 v96, v96, s37, v5
    v_lshrrev_b32 v97, 10, v48
    v_and_or_b32 v97, v48, 64, v97
    v_and_or_b32 v97, v97, s37, v5
    s_mov_b64 exec, s[56:57]
    ds_add_rtn_u32 v106, v89, v11
    s_mov_b64 exec, s[58:59]
    ds_add_rtn_u32 v107, v90, v11
    s_mov_b64 exec, s[60:61]
    ds_add_rtn_u32 v108, v91, v11
    s_mov_b64 exec, s[62:63]
    ds_add_rtn_u32 v109, v92, v11
    s_mov_b64 exec, s[64:65]
    ds_add_rtn_u32 v110, v93, v11
    s_mov_b64 exec, s[66:67]
    ds_add_rtn_u32 v111, v94, v11
    s_mov_b64 exec, s[68:69]
    ds_add_rtn_u32 v112, v95, v11
    s_mov_b64 exec, s[70:71]
    ds_add_rtn_u32 v113, v96, v11
    s_mov_b64 exec, s[72:73]
    ds_add_rtn_u32 v114, v97, v11
    s_mov_b64 exec, -1
    ds_read_b32 v7, v10
    s_waitcnt lgkmcnt(0)
    v_mov_b32 v8, v7
    s_nop 1
    v_add_u32_dpp v8, v8, v8 row_shr:1 row_mask:0xf bank_mask:0xf bound_ctrl:0
    s_nop 1
    v_add_u32_dpp v8, v8, v8 row_shr:2 row_mask:0xf bank_mask:0xf bound_ctrl:0
    s_nop 1
    v_add_u32_dpp v8, v8, v8 row_shr:4 row_mask:0xf bank_mask:0xf bound_ctrl:0
    s_nop 1
    v_add_u32_dpp v8, v8, v8 row_shr:8 row_mask:0xf bank_mask:0xf bound_ctrl:0
    s_nop 1
    v_add_u32_dpp v8, v8, v8 row_bcast:15 row_mask:0xa bank_mask:0xf
    v_sub_u32 v7, v8, v7
    v_add_u32 v7, v7, v25
    ds_write_b32 v10, v7
    v_readlane_b32 s31, v8, 31
    v_readlane_b32 s32, v8, 63
    ds_read_b32 v81, v81
    ds_read_b32 v82, v82
    ds_read_b32 v83, v83
    ds_read_b32 v84, v84
    ds_read_b32 v85, v85
    ds_read_b32 v86, v86
    ds_read_b32 v87, v87
    ds_read_b32 v88, v88
    ds_read_b32 v89, v89
    ds_read_b32 v90, v90
    ds_read_b32 v91, v91
    ds_read_b32 v92, v92
    ds_read_b32 v93, v93
    ds_read_b32 v94, v94
    ds_read_b32 v95, v95
    ds_read_b32 v96, v96
    ds_read_b32 v97, v97
    s_max_u32 s38, s31, s32
    s_add_u32 s38, s38, 31
    s_lshr_b32 s38, s38, 5
    s_max_u32 s38, s38, 4
    v_add_u32 v8, s31, v26
    s_mov_b32 exec_lo, 0
    v_add_u32 v8, s32, v26
    s_mov_b32 exec_lo, -1
    s_min_u32 s31, s31, s32
    s_lshl_b32 s32, s38, 5
    v_add_u32 v9, s32, v25
    s_sub_u32 s31, s32, s31
L_pad:
    v_cmp_lt_u32 vcc, v8, v9
    s_mov_b64 exec, vcc
    ds_write2st64_b32 v8, v16, v17 offset0:0 offset1:18
    v_add_u32 v8, 128, v8
    s_sub_i32 s31, s31, 128
    s_cmp_gt_i32 s31, 0
    s_cbranch_scc1 L_pad
    s_mov_b64 exec, -1
    s_sub_u32 s38, s38, 2
    s_mov_b64 vcc, 0
    v_cvt_f32_u32 v7, s38
    v_rcp_f32 v7, v7
    v_mov_b32 v6, s3
    v_mul_f32 v7, 0x47800000, v7
    v_cvt_u32_f32 v7, v7
    s_nop 0
    v_readfirstlane_b32 s11, v7
    s_waitcnt lgkmcnt(9)
    v_add_u32 v81, v81, v98
    v_add_u32 v82, v82, v99
    v_add_u32 v83, v83, v100
    v_add_u32 v84, v84, v101
    v_add_u32 v85, v85, v102
    v_add_u32 v86, v86, v103
    v_add_u32 v87, v87, v104
    v_add_u32 v88, v88, v105
    v_add_u32 v89, v89, v106
    s_waitcnt lgkmcnt(1)
    v_add_u32 v90, v90, v107
    v_add_u32 v91, v91, v108
    v_add_u32 v92, v92, v109
    v_add_u32 v93, v93, v110
    v_add_u32 v94, v94, v111
    v_add_u32 v95, v95, v112
    v_add_u32 v96, v96, v113
    v_add_u32 v97, v97, v114
    s_mov_b64 exec, s[40:41]
    ds_write2st64_b32 v81, v32, v64 offset0:0 offset1:18
    s_mov_b64 exec, s[42:43]
    ds_write2st64_b32 v82, v33, v65 offset0:0 offset1:18
    s_mov_b64 exec, s[44:45]
    ds_write2st64_b32 v83, v34, v66 offset0:0 offset1:18
    s_mov_b64 exec, s[46:47]
    ds_write2st64_b32 v84, v35, v67 offset0:0 offset1:18
    s_mov_b64 exec, s[48:49]
    ds_write2st64_b32 v85, v36, v68 offset0:0 offset1:18
    s_mov_b64 exec, s[50:51]
    ds_write2st64_b32 v86, v37, v69 offset0:0 offset1:18
    s_mov_b64 exec, s[52:53]
    ds_write2st64_b32 v87, v38, v70 offset0:0 offset1:18
    s_mov_b64 exec, s[54:55]
    ds_write2st64_b32 v88, v39, v71 offset0:0 offset1:18
    s_mov_b64 exec, s[56:57]
    ds_write2st64_b32 v89, v40, v72 offset0:0 offset1:18
    s_mov_b64 exec, s[58:59]
    ds_write2st64_b32 v90, v41, v73 offset0:0 offset1:18
    s_mov_b64 exec, s[60:61]
    ds_write2st64_b32 v91, v42, v74 offset0:0 offset1:18
    s_mov_b64 exec, s[62:63]
    ds_write2st64_b32 v92, v43, v75 offset0:0 offset1:18
    s_mov_b64 exec, s[64:65]
    ds_write2st64_b32 v93, v44, v76 offset0:0 offset1:18
    s_mov_b64 exec, s[66:67]
    ds_write2st64_b32 v94, v45, v77 offset0:0 offset1:18
    s_mov_b64 exec, s[68:69]
    ds_write2st64_b32 v95, v46, v78 offset0:0 offset1:18
    s_mov_b64 exec, s[70:71]
    ds_write2st64_b32 v96, v47, v79 offset0:0 offset1:18
    s_mov_b64 exec, s[72:73]
    ds_write2st64_b32 v97, v48, v80 offset0:0 offset1:18
    s_mov_b64 exec, -1
    ds_read_b64 v[16:17], v4 offset:0
    ds_read_b64 v[18:19], v4 offset:4608
    ds_read_b64 v[20:21], v4 offset:32
    ds_read_b64 v[22:23], v4 offset:4640
    ds_read_b64 v[24:25], v4 offset:64
    ds_read_b64 v[26:27], v4 offset:4672
    ds_read_b64 v[28:29], v4 offset:96
    ds_read_b64 v[30:31], v4 offset:4704
    s_waitcnt vmcnt(0) lgkmcnt(0)
    s_setprio 1
    v_lshl_or_b32 v16, v16, 7, v2
    v_lshl_or_b32 v17, v17, 7, v2
    buffer_load_dwordx4 v[32:35], v16, s[20:23], 0 offen
    buffer_load_dwordx4 v[36:39], v17, s[20:23], 0 offen
    v_lshl_or_b32 v20, v20, 7, v2
    v_lshl_or_b32 v21, v21, 7, v2
    buffer_load_dwordx4 v[40:43], v20, s[20:23], 0 offen
    buffer_load_dwordx4 v[44:47], v21, s[20:23], 0 offen
    v_mov_b32 v96, 0
    v_mov_b32 v97, 0
    v_mov_b32 v98, 0
    v_mov_b32 v99, 0
    v_mov_b32 v100, 0
    v_mov_b32 v101, 0
    v_mov_b32 v102, 0
    v_mov_b32 v103, 0
    v_mov_b32 v104, 0
    v_mov_b32 v105, 0
    v_mov_b32 v106, 0
    v_mov_b32 v107, 0
    v_mov_b32 v108, 0
    v_mov_b32 v109, 0
    v_mov_b32 v110, 0
    v_mov_b32 v111, 0
    v_mov_b32 v112, 0
    v_mov_b32 v113, 0
    v_mov_b32 v114, 0
    v_mov_b32 v115, 0
    v_mov_b32 v116, 0
    v_mov_b32 v117, 0
    v_mov_b32 v118, 0
    v_mov_b32 v119, 0
    v_mov_b32 v120, 0
    v_mov_b32 v121, 0
    v_mov_b32 v122, 0
    v_mov_b32 v123, 0
    v_mov_b32 v124, 0
    v_mov_b32 v125, 0
    v_mov_b32 v126, 0
    v_mov_b32 v127, 0
    s_mul_i32 s31, s38, s11
    v_mov_b32 v11, s31
    s_mov_b64 exec, 1
    ds_write_b32 v6, v11
    s_mov_b64 exec, -1
    ds_read_b32 v5, v0
L_loop:
    s_sub_u32 s38, s38, 1
    s_cbranch_scc1 L_tail0
    s_waitcnt lgkmcnt(0)
    v_cmp_gt_u32 vcc, v5, v11
    s_and_b32 s30, vcc_lo, 65535
    s_bcnt1_i32_b32 s30, s30
    s_setprio 1
    s_cmp_lt_u32 s30, 13
    s_cbranch_scc1 L_deep0
    s_setprio 0
    s_waitcnt vmcnt(0)
L_deep0:
    v_lshl_or_b32 v24, v24, 7, v2
    v_lshl_or_b32 v25, v25, 7, v2
    buffer_load_dwordx4 v[48:51], v24, s[20:23], 0 offen
    buffer_load_dwordx4 v[52:55], v25, s[20:23], 0 offen
    v_xad_u32 v18, v18, v3, s36
    v_xad_u32 v19, v19, v3, s36
    v_cvt_pk_i16_i32 v12, v18, v19
    ds_read_b64 v[16:17], v4 offset:128
    ds_read_b64 v[18:19], v4 offset:4736
    s_waitcnt vmcnt(4)
    v_perm_b32 v64, v36, v32, s34
    v_perm_b32 v68, v36, v32, s35
    v_perm_b32 v72, v37, v33, s34
    v_perm_b32 v76, v37, v33, s35
    v_perm_b32 v80, v38, v34, s34
    v_perm_b32 v84, v38, v34, s35
    v_perm_b32 v88, v39, v35, s34
    v_perm_b32 v92, v39, v35, s35
    s_sub_u32 s38, s38, 1
    s_cbranch_scc1 L_tail1
    s_waitcnt lgkmcnt(0)
    s_cmp_lt_u32 s30, 13
    s_cbranch_scc1 L_deep1
    s_setprio 0
    s_waitcnt vmcnt(0)
L_deep1:
    v_lshl_or_b32 v28, v28, 7, v2
    v_lshl_or_b32 v29, v29, 7, v2
    buffer_load_dwordx4 v[56:59], v28, s[20:23], 0 offen
    buffer_load_dwordx4 v[60:63], v29, s[20:23], 0 offen
    s_mul_i32 s31, s38, s11
    v_mov_b32 v11, s31
    s_mov_b64 exec, 1
    ds_write_b32 v6, v11
    s_mov_b64 exec, -1
    ds_read_b32 v5, v0
    v_xad_u32 v22, v22, v3, s36
    v_xad_u32 v23, v23, v3, s36
    v_cvt_pk_i16_i32 v13, v22, v23
    ds_read_b64 v[20:21], v4 offset:160
    ds_read_b64 v[22:23], v4 offset:4768
    s_waitcnt vmcnt(4)
    v_perm_b32 v65, v44, v40, s34
    v_perm_b32 v69, v44, v40, s35
    v_perm_b32 v73, v45, v41, s34
    v_perm_b32 v77, v45, v41, s35
    v_perm_b32 v81, v46, v42, s34
    v_perm_b32 v85, v46, v42, s35
    v_perm_b32 v89, v47, v43, s34
    v_perm_b32 v93, v47, v43, s35
    s_sub_u32 s38, s38, 1
    s_cbranch_scc1 L_tail2
    s_waitcnt lgkmcnt(0)
    v_cmp_gt_u32 vcc, v5, v11
    s_and_b32 s30, vcc_lo, 65535
    s_bcnt1_i32_b32 s30, s30
    s_setprio 1
    s_cmp_lt_u32 s30, 13
    s_cbranch_scc1 L_deep2
    s_setprio 0
    s_waitcnt vmcnt(0)
L_deep2:
    v_lshl_or_b32 v16, v16, 7, v2
    v_lshl_or_b32 v17, v17, 7, v2
    buffer_load_dwordx4 v[32:35], v16, s[20:23], 0 offen
    buffer_load_dwordx4 v[36:39], v17, s[20:23], 0 offen
    v_xad_u32 v26, v26, v3, s36
    v_xad_u32 v27, v27, v3, s36
    v_cvt_pk_i16_i32 v14, v26, v27
    ds_read_b64 v[24:25], v4 offset:192
    ds_read_b64 v[26:27], v4 offset:4800
    s_waitcnt vmcnt(4)
    v_perm_b32 v66, v52, v48, s34
    v_perm_b32 v70, v52, v48, s35
    v_perm_b32 v74, v53, v49, s34
    v_perm_b32 v78, v53, v49, s35
    v_perm_b32 v82, v54, v50, s34
    v_perm_b32 v86, v54, v50, s35
    v_perm_b32 v90, v55, v51, s34
    v_perm_b32 v94, v55, v51, s35
    s_sub_u32 s38, s38, 1
    s_cbranch_scc1 L_tail3
    s_waitcnt lgkmcnt(0)
    s_cmp_lt_u32 s30, 13
    s_cbranch_scc1 L_deep3
    s_setprio 0
    s_waitcnt vmcnt(0)
L_deep3:
    v_lshl_or_b32 v20, v20, 7, v2
    v_lshl_or_b32 v21, v21, 7, v2
    buffer_load_dwordx4 v[40:43], v20, s[20:23], 0 offen
    buffer_load_dwordx4 v[44:47], v21, s[20:23], 0 offen
    s_mul_i32 s31, s38, s11
    v_mov_b32 v11, s31
    s_mov_b64 exec, 1
    ds_write_b32 v6, v11
    s_mov_b64 exec, -1
    ds_read_b32 v5, v0
    v_xad_u32 v30, v30, v3, s36
    v_xad_u32 v31, v31, v3, s36
    v_cvt_pk_i16_i32 v15, v30, v31
    ds_read_b64 v[28:29], v4 offset:224
    ds_read_b64 v[30:31], v4 offset:4832
    s_waitcnt vmcnt(4)
    v_perm_b32 v67, v60, v56, s34
    v_perm_b32 v71, v60, v56, s35
    v_perm_b32 v75, v61, v57, s34
    v_perm_b32 v79, v61, v57, s35
    v_perm_b32 v83, v62, v58, s34
    v_perm_b32 v87, v62, v58, s35
    v_perm_b32 v91, v63, v59, s34
    v_perm_b32 v95, v63, v59, s35
    v_add_u32 v4, 128, v4
    s_nop 0
    v_mfma_f32_16x16x32_bf16 v[96:99], v[12:15], v[64:67], v[96:99]
    v_mfma_f32_16x16x32_bf16 v[100:103], v[12:15], v[68:71], v[100:103]
    v_mfma_f32_16x16x32_bf16 v[104:107], v[12:15], v[72:75], v[104:107]
    v_mfma_f32_16x16x32_bf16 v[108:111], v[12:15], v[76:79], v[108:111]
    v_mfma_f32_16x16x32_bf16 v[112:115], v[12:15], v[80:83], v[112:115]
    v_mfma_f32_16x16x32_bf16 v[116:119], v[12:15], v[84:87], v[116:119]
    v_mfma_f32_16x16x32_bf16 v[120:123], v[12:15], v[88:91], v[120:123]
    v_mfma_f32_16x16x32_bf16 v[124:127], v[12:15], v[92:95], v[124:127]
    s_branch L_loop
L_tail0:
    v_xad_u32 v18, v18, v3, s36
    v_xad_u32 v19, v19, v3, s36
    v_cvt_pk_i16_i32 v12, v18, v19
    s_waitcnt vmcnt(2)
    v_perm_b32 v64, v36, v32, s34
    v_perm_b32 v68, v36, v32, s35
    v_perm_b32 v72, v37, v33, s34
    v_perm_b32 v76, v37, v33, s35
    v_perm_b32 v80, v38, v34, s34
    v_perm_b32 v84, v38, v34, s35
    v_perm_b32 v88, v39, v35, s34
    v_perm_b32 v92, v39, v35, s35
    v_xad_u32 v22, v22, v3, s36
    v_xad_u32 v23, v23, v3, s36
    v_cvt_pk_i16_i32 v13, v22, v23
    s_waitcnt vmcnt(0)
    v_perm_b32 v65, v44, v40, s34
    v_perm_b32 v69, v44, v40, s35
    v_perm_b32 v73, v45, v41, s34
    v_perm_b32 v77, v45, v41, s35
    v_perm_b32 v81, v46, v42, s34
    v_perm_b32 v85, v46, v42, s35
    v_perm_b32 v89, v47, v43, s34
    v_perm_b32 v93, v47, v43, s35
    v_mov_b32 v14, 0
    v_mov_b32 v15, 0
    s_branch L_fin
L_tail1:
    v_xad_u32 v22, v22, v3, s36
    v_xad_u32 v23, v23, v3, s36
    v_cvt_pk_i16_i32 v13, v22, v23
    s_waitcnt vmcnt(2)
    v_perm_b32 v65, v44, v40, s34
    v_perm_b32 v69, v44, v40, s35
    v_perm_b32 v73, v45, v41, s34
    v_perm_b32 v77, v45, v41, s35
    v_perm_b32 v81, v46, v42, s34
    v_perm_b32 v85, v46, v42, s35
    v_perm_b32 v89, v47, v43, s34
    v_perm_b32 v93, v47, v43, s35
    v_xad_u32 v26, v26, v3, s36
    v_xad_u32 v27, v27, v3, s36
    v_cvt_pk_i16_i32 v14, v26, v27
    s_waitcnt vmcnt(0)
    v_perm_b32 v66, v52, v48, s34
    v_perm_b32 v70, v52, v48, s35
    v_perm_b32 v74, v53, v49, s34
    v_perm_b32 v78, v53, v49, s35
    v_perm_b32 v82, v54, v50, s34
    v_perm_b32 v86, v54, v50, s35
    v_perm_b32 v90, v55, v51, s34
    v_perm_b32 v94, v55, v51, s35
    v_mov_b32 v15, 0
    s_branch L_fin
L_tail2:
    v_xad_u32 v26, v26, v3, s36
    v_xad_u32 v27, v27, v3, s36
    v_cvt_pk_i16_i32 v14, v26, v27
    s_waitcnt vmcnt(2)
    v_perm_b32 v66, v52, v48, s34
    v_perm_b32 v70, v52, v48, s35
    v_perm_b32 v74, v53, v49, s34
    v_perm_b32 v78, v53, v49, s35
    v_perm_b32 v82, v54, v50, s34
    v_perm_b32 v86, v54, v50, s35
    v_perm_b32 v90, v55, v51, s34
    v_perm_b32 v94, v55, v51, s35
    v_xad_u32 v30, v30, v3, s36
    v_xad_u32 v31, v31, v3, s36
    v_cvt_pk_i16_i32 v15, v30, v31
    s_waitcnt vmcnt(0)
    v_perm_b32 v67, v60, v56, s34
    v_perm_b32 v71, v60, v56, s35
    v_perm_b32 v75, v61, v57, s34
    v_perm_b32 v79, v61, v57, s35
    v_perm_b32 v83, v62, v58, s34
    v_perm_b32 v87, v62, v58, s35
    v_perm_b32 v91, v63, v59, s34
    v_perm_b32 v95, v63, v59, s35
    s_branch L_fin
L_tail3:
    v_xad_u32 v30, v30, v3, s36
    v_xad_u32 v31, v31, v3, s36
    v_cvt_pk_i16_i32 v15, v30, v31
    s_waitcnt vmcnt(2)
    v_perm_b32 v67, v60, v56, s34
    v_perm_b32 v71, v60, v56, s35
    v_perm_b32 v75, v61, v57, s34
    v_perm_b32 v79, v61, v57, s35
    v_perm_b32 v83, v62, v58, s34
    v_perm_b32 v87, v62, v58, s35
    v_perm_b32 v91, v63, v59, s34
    v_perm_b32 v95, v63, v59, s35
    s_nop 1
    v_mfma_f32_16x16x32_bf16 v[96:99], v[12:15], v[64:67], v[96:99]
    v_mfma_f32_16x16x32_bf16 v[100:103], v[12:15], v[68:71], v[100:103]
    v_mfma_f32_16x16x32_bf16 v[104:107], v[12:15], v[72:75], v[104:107]
    v_mfma_f32_16x16x32_bf16 v[108:111], v[12:15], v[76:79], v[108:111]
    v_mfma_f32_16x16x32_bf16 v[112:115], v[12:15], v[80:83], v[112:115]
    v_mfma_f32_16x16x32_bf16 v[116:119], v[12:15], v[84:87], v[116:119]
    v_mfma_f32_16x16x32_bf16 v[120:123], v[12:15], v[88:91], v[120:123]
    v_mfma_f32_16x16x32_bf16 v[124:127], v[12:15], v[92:95], v[124:127]
    v_xad_u32 v18, v18, v3, s36
    v_xad_u32 v19, v19, v3, s36
    v_cvt_pk_i16_i32 v12, v18, v19
    s_waitcnt vmcnt(0)
    v_perm_b32 v64, v36, v32, s34
    v_perm_b32 v68, v36, v32, s35
    v_perm_b32 v72, v37, v33, s34
    v_perm_b32 v76, v37, v33, s35
    v_perm_b32 v80, v38, v34, s34
    v_perm_b32 v84, v38, v34, s35
    v_perm_b32 v88, v39, v35, s34
    v_perm_b32 v92, v39, v35, s35
    v_mov_b32 v13, 0
    v_mov_b32 v14, 0
    v_mov_b32 v15, 0
L_fin:
    v_mov_b32 v11, 0
    s_mov_b64 exec, 1
    ds_write_b32 v6, v11
    s_mov_b64 exec, -1
    s_waitcnt lgkmcnt(0)
    s_nop 0
    v_mfma_f32_16x16x32_bf16 v[96:99], v[12:15], v[64:67], v[96:99]
    v_mfma_f32_16x16x32_bf16 v[100:103], v[12:15], v[68:71], v[100:103]
    v_mfma_f32_16x16x32_bf16 v[104:107], v[12:15], v[72:75], v[104:107]
    v_mfma_f32_16x16x32_bf16 v[108:111], v[12:15], v[76:79], v[108:111]
    v_mfma_f32_16x16x32_bf16 v[112:115], v[12:15], v[80:83], v[112:115]
    v_mfma_f32_16x16x32_bf16 v[116:119], v[12:15], v[84:87], v[116:119]
    v_mfma_f32_16x16x32_bf16 v[120:123], v[12:15], v[88:91], v[120:123]
    v_mfma_f32_16x16x32_bf16 v[124:127], v[12:15], v[92:95], v[124:127]
    v_lshrrev_b32 v9, 2, v1
    v_xor_b32 v7, v9, v1
    v_and_b32 v9, 4, v9
    v_bfe_u32 v7, v7, 3, 1
    v_lshl_or_b32 v7, v7, 1, v9
    v_lshl_or_b32 v8, v7, 7, v2
    v_lshrrev_b32 v7, v7, s74
    v_bfe_i32 v9, v1, 5, 1
    v_xor_b32 v7, v7, v9
    v_bfe_u32 v16, v7, 0, 1
    v_lshl_or_b32 v16, v16, 10, v8
    v_bfe_u32 v17, v7, 1, 1
    v_lshl_or_b32 v17, v17, 10, v8
    s_lshl_b32 s31, s29, 11
    s_mov_b32 vcc_lo, 0x00ff00ff
    s_mov_b32 vcc_hi, 0xff00ff00
    s_nop 3
    v_cvt_pk_bf16_f32 v40, v98, v102
    v_cvt_pk_bf16_f32 v41, v106, v110
    v_cvt_pk_bf16_f32 v42, v114, v118
    v_cvt_pk_bf16_f32 v43, v122, v126
    v_cvt_pk_bf16_f32 v32, v96, v100
    v_cvt_pk_bf16_f32 v33, v104, v108
    v_cvt_pk_bf16_f32 v34, v112, v116
    v_cvt_pk_bf16_f32 v35, v120, v124
    v_cndmask_b32_dpp v32, v40, v32, vcc row_ror:8 row_mask:0xf bank_mask:0xf
    v_cndmask_b32_dpp v33, v41, v33, vcc row_ror:8 row_mask:0xf bank_mask:0xf
    v_cndmask_b32_dpp v34, v42, v34, vcc row_ror:8 row_mask:0xf bank_mask:0xf
    v_cndmask_b32_dpp v35, v43, v35, vcc row_ror:8 row_mask:0xf bank_mask:0xf
    buffer_store_dwordx4 v[32:35], v16, s[24:27], s31 offen offset:0 sc1
    v_cvt_pk_bf16_f32 v44, v99, v103
    v_cvt_pk_bf16_f32 v45, v107, v111
    v_cvt_pk_bf16_f32 v46, v115, v119
    v_cvt_pk_bf16_f32 v47, v123, v127
    v_cvt_pk_bf16_f32 v36, v97, v101
    v_cvt_pk_bf16_f32 v37, v105, v109
    v_cvt_pk_bf16_f32 v38, v113, v117
    v_cvt_pk_bf16_f32 v39, v121, v125
    v_cndmask_b32_dpp v36, v44, v36, vcc row_ror:8 row_mask:0xf bank_mask:0xf
    v_cndmask_b32_dpp v37, v45, v37, vcc row_ror:8 row_mask:0xf bank_mask:0xf
    v_cndmask_b32_dpp v38, v46, v38, vcc row_ror:8 row_mask:0xf bank_mask:0xf
    v_cndmask_b32_dpp v39, v47, v39, vcc row_ror:8 row_mask:0xf bank_mask:0xf
    buffer_store_dwordx4 v[36:39], v17, s[24:27], s31 offen offset:128 sc1
L_end:
    s_endpgm
.section .rodata,"a"
.p2align 6
.amdhsa_kernel standalone__sparse_matmul_formats_ell__sparse_mat_kernel
  .amdhsa_next_free_vgpr 128
  .amdhsa_next_free_sgpr 76
  .amdhsa_accum_offset 128
  .amdhsa_group_segment_fixed_size 0
  .amdhsa_kernarg_size 48
  .amdhsa_user_sgpr_count 2
  .amdhsa_user_sgpr_kernarg_segment_ptr 1
  .amdhsa_system_sgpr_workgroup_id_x 1
.end_amdhsa_kernel
```
